```python
import torch

def _softmax(x, axis=-1):
    return torch.softmax(x, dim=axis)
def _gelu(x):
    return torch.nn.functional.gelu(x, approximate="tanh")
def _silu(x):
    return torch.nn.functional.silu(x)
def _sigmoid(x):
    return torch.sigmoid(x)
def _layernorm(x, axis=-1, eps=1e-5):
    m = x.mean(dim=axis, keepdim=True)
    v = x.var(dim=axis, keepdim=True, unbiased=False)
    return (x - m) / torch.sqrt(v + eps)
def _scatter_add(tgt, idx, src, axis=0):
    return tgt.clone().index_add_(axis, idx, src)
def _segment_sum(src, seg, n):
    out = torch.zeros((n,) + src.shape[1:], dtype=src.dtype)
    return out.index_add_(0, seg, src)
def _pad(x, pw):
    flat = tuple(v for pair in reversed(pw) for v in pair)
    return torch.nn.functional.pad(x, flat)

kernel_name = 'parallel_sum__sliding_block_cached__glu_gated_geglu__decode'

def setup_inputs():

    _w = (lambda a: (lambda t: t.to(torch.bfloat16) if t.is_floating_point() else t)(torch.as_tensor(a)))
    def _A_setup():
        B, Sq, D = 2, 1, 640
        Hq, Hkv, Sk, Dh = 32, 32, 8192, 192
        assert Hq % Hkv == 0, (Hq, Hkv)
        return {
            "x": _w((lambda *s: torch.randn(*s, dtype=torch.bfloat16) * 0.05)(B, Sq, D)),
            "k_cache": _w((lambda *s: torch.randn(*s, dtype=torch.bfloat16) * 1.6)(B, Hkv, Sk, Dh)),
            "v_cache": _w((lambda *s: torch.randn(*s, dtype=torch.bfloat16) * 0.8)(B, Hkv, Sk, Dh)),
            "wq": _w((lambda *s: torch.randn(*s, dtype=torch.bfloat16) * 1.6)(D, Hq * Dh) * (D ** -0.5)),
            "wo": _w((lambda *s: torch.randn(*s, dtype=torch.bfloat16) * 0.8)(Hq * Dh, D) * ((Hq * Dh) ** -0.5)),
        }
    _A_in = _A_setup()

    def _B_setup():
        B, S, Dm, Df = 2, 1, 640, 1536
        return {
            "x": _w((lambda *s: torch.randn(*s, dtype=torch.bfloat16) * 0.05)(B, S, Dm)),
            "w_gate": _w((lambda *s: torch.randn(*s, dtype=torch.bfloat16) * 0.8)(Dm, Df) * (Dm ** -0.5)),
            "w_up": _w((lambda *s: torch.randn(*s, dtype=torch.bfloat16) * 0.8)(Dm, Df) * (Dm ** -0.5)),
            "w_down": _w((lambda *s: torch.randn(*s, dtype=torch.bfloat16) * 0.8)(Df, Dm) * (Df ** -0.5)),
        }
    _B_in = _B_setup()

    return {
        "A_x": _A_in["x"],
        "A_k_cache": _A_in["k_cache"],
        "A_v_cache": _A_in["v_cache"],
        "A_wq": _A_in["wq"],
        "A_wo": _A_in["wo"],
        "B_x": _B_in["x"],
        "B_w_gate": _B_in["w_gate"],
        "B_w_up": _B_in["w_up"],
        "B_w_down": _B_in["w_down"],
    }

def reference(A_x, A_k_cache, A_v_cache, A_wq, A_wo, B_x, B_w_gate, B_w_up, B_w_down):
    def _A_ref(x, k_cache, v_cache, wq, wo):
        B, Sq, D = x.shape
        Hq, Dh = 32, 192
        Hkv, Sk = k_cache.shape[1], k_cache.shape[2]
        W = min(4096, max(256, Sk // 4))
        rep = Hq // Hkv
        q = (lambda x, *d: x.permute(*d))((x @ wq).reshape(B, Sq, Hq, Dh), 0, 2, 1, 3)
        k = (lambda x, n, axis: torch.repeat_interleave(x, n, dim=axis))(k_cache[:, :, Sk - W:, :], rep, axis=1)
        v = (lambda x, n, axis: torch.repeat_interleave(x, n, dim=axis))(v_cache[:, :, Sk - W:, :], rep, axis=1)
        scores = torch.einsum("bhqd,bhkd->bhqk", q, k) * (Dh ** -0.5)
        p = _softmax(scores, axis=-1)
        o = torch.einsum("bhqk,bhkd->bhqd", p, v)
        return (lambda x, *d: x.permute(*d))(o, 0, 2, 1, 3).reshape(B, Sq, Hq * Dh) @ wo

    def _B_ref(x, w_gate, w_up, w_down):
        g = torch.einsum("bsd,df->bsf", x, w_gate)
        u = torch.einsum("bsd,df->bsf", x, w_up)
        h = _gelu(g) * u
        return torch.einsum("bsf,fd->bsd", h, w_down)

    x = A_x
    xn = _layernorm(x, axis=-1)
    return x + _A_ref(xn, A_k_cache, A_v_cache, A_wq, A_wo) + _B_ref(xn, B_w_gate, B_w_up, B_w_down)
```

```asm
; @launch grid=(256,1,1) block=(512,1,1) lds=58368
.amdgcn_target "amdgcn-amd-amdhsa--gfx950"
.text
.p2align 12
.fill 832, 4, 0xbf800000
.globl parallel_sum__sliding_block_cached__glu_gated_geglu__decode_kernel
.p2align 8
.type parallel_sum__sliding_block_cached__glu_gated_geglu__decode_kernel,@function
parallel_sum__sliding_block_cached__glu_gated_geglu__decode_kernel:
    s_cmp_ge_u32 s2, 0x100
    s_cbranch_scc1 L_end
    s_load_dwordx2 s[4:5], s[0:1], 0
    s_load_dwordx2 s[16:17], s[0:1], 24
    s_load_dwordx2 s[24:25], s[0:1], 48
    s_load_dwordx2 s[28:29], s[0:1], 56
    s_load_dwordx2 s[8:9], s[0:1], 8
    s_load_dwordx2 s[40:41], s[0:1], 88
    s_load_dwordx2 s[12:13], s[0:1], 16
    s_load_dwordx2 s[20:21], s[0:1], 32
    s_load_dwordx2 s[32:33], s[0:1], 64
    s_load_dwordx2 s[36:37], s[0:1], 72
    v_lshrrev_b32 v9, 6, v0
    v_and_b32 v2, 15, v0
    v_readfirstlane_b32 s44, v9
    v_bfe_u32 v3, v0, 4, 2
    s_and_b32 s45, s2, 7
    s_bfe_u32 s72, s2, 0x20003
    s_mul_i32 s73, s45, 0x180
    s_lshl_b32 s45, s45, 2
    s_add_u32 s45, s45, s72
    s_lshr_b32 s46, s2, 5
    s_lshl_b32 s75, s72, 5
    s_add_u32 s73, s73, s75
    s_add_u32 s75, s73, s75
    s_mul_i32 s72, s45, 6
    s_add_u32 s72, s72, s46
    s_lshl_b32 s72, s72, 6
    s_cmp_lt_u32 s46, 6
    s_cselect_b32 s72, s72, s75
    s_cselect_b32 s52, 4, 1
    s_mul_i32 s52, s52, 0xc00
    s_bitset0_b32 s72, 6
    s_lshr_b32 s47, s2, 7
    v_and_b32 v10, 7, v0
    v_bfe_u32 v11, v0, 3, 1
    v_lshlrev_b32 v12, 4, v2
    v_lshlrev_b32 v13, 4, v10
    v_mul_u32_u24 v14, 0x500, v11
    v_lshl_add_u32 v15, v3, 3, v10
    v_mad_u32_u24 v15, v15, 40, v14
    v_bfe_u32 v17, v0, 2, 4
    v_and_b32 v21, 3, v0
    v_bfe_u32 v18, v0, 3, 3
    v_bfe_u32 v9, v0, 5, 1
    v_mul_u32_u24 v16, s52, v18
    v_xor_b32 v9, v18, v9
    v_and_b32 v9, 3, v9
    v_lshlrev_b32 v9, 5, v9
    v_xor_b32 v9, v9, v13
    v_add_u32 v16, v16, v9
    v_mul_u32_u24 v18, 0xc00, v17
    v_lshl_add_u32 v18, v21, 4, v18
    v_mov_b32 v19, 0x7fff0000
    v_lshrrev_b32 v20, 2, v2
    v_mul_u32_u24 v22, 0x180, v20
    v_lshl_add_u32 v23, v3, 2, v21
    v_lshl_add_u32 v22, v23, 4, v22
    v_bfe_u32 v27, v0, 5, 1
    v_lshl_add_u32 v23, v27, 2, v20
    v_mul_u32_u24 v23, 0x180, v23
    v_bfe_u32 v24, v0, 4, 1
    v_lshl_add_u32 v25, v24, 2, v21
    v_lshl_add_u32 v23, v25, 4, v23
    v_mov_b32 v25, 0
    s_mov_b32 s42, 2428928
    s_mov_b32 s43, 0x20000
    s_mov_b32 s6, 2560
    s_mov_b32 s7, 0x20000
    s_mul_i32 s18, s52, 640
    s_mov_b32 s19, 0x20000
    s_mov_b32 s26, 1966080
    s_mov_b32 s27, 0x20000
    s_mov_b32 s10, 595968
    s_mov_b32 s11, 0x20000
    s_bitset0_b32 s73, 5
    s_mul_i32 s74, s46, 0x3c000
    s_add_u32 s73, s73, s74
    s_add_u32 s73, s73, 0x100
    s_and_b32 s53, s46, 1
    s_lshl3_add_u32 s60, s53, s44
    s_mul_i32 s60, s60, 40
    s_mul_i32 s53, s60, s52
    s_lshl_b32 s57, s52, 3
    s_add_u32 s53, s53, s72
    v_add_u32 v16, s53, v16
    s_sub_u32 s58, s57, 0x400
    v_add_u32 v232, s58, v16
    v_add_u32 v233, s58, v232
    v_add_u32 v234, s58, v233
    v_lshl_add_u32 v235, s57, 2, v16
    s_sub_u32 s58, s44, 3
    s_mul_i32 s58, s58, 0xc000
    s_add_u32 s73, s73, s58
    v_add_u32 v18, s73, v18
    s_mul_i32 s79, s44, 6144
    s_add_u32 m0, s79, 0x1400
    s_lshl_b32 s76, s47, 5
    s_add_u32 s76, s76, s45
    s_and_b32 s77, s46, 3
    s_lshl_b32 s76, s76, 9
    s_lshl_b32 s77, s77, 3
    s_add_u32 s76, s76, s77
    s_add_u32 s76, s76, 384
    s_add_u32 s76, s76, s44
    s_mul_i32 s76, s76, 0x1800
    s_mov_b32 s59, 2359296
    s_cmp_lg_u32 s44, 0
    s_waitcnt lgkmcnt(0)
    s_cbranch_scc1 L_nox
    buffer_load_dwordx4 v[200:203], v15, s[4:7], 0 offen
    buffer_load_dwordx4 v[204:207], v15, s[4:7], 0 offen offset:16
    buffer_load_dwordx2 v[208:209], v15, s[4:7], 0 offen offset:32
    buffer_load_dword v8, v25, s[40:43], s59 offen sc1
L_nox:
    s_bitcmp1_b32 s45, 0
    s_cselect_b64 s[24:25], s[28:29], s[24:25]
    s_cmp_lt_u32 s46, 6
    s_cselect_b64 s[16:17], s[16:17], s[24:25]
    s_cmp_lt_u32 s44, 3
    s_cbranch_scc1 L_nou1
    buffer_load_dwordx4 v18, s[24:27], 0 offen nt lds
L_nou1:
    s_mov_b32 m0, s79
    s_nop 0
    buffer_load_dwordx4 v16, s[16:19], 0 offen offset:0 nt lds
    buffer_load_dwordx4 v232, s[16:19], 0 offen offset:1024 nt lds
    buffer_load_dwordx4 v233, s[16:19], 0 offen offset:2048 nt lds
    buffer_load_dwordx4 v234, s[16:19], 0 offen offset:3072 nt lds
    s_addk_i32 m0, 0x1000
    s_nop 0
    buffer_load_dwordx4 v235, s[16:19], 0 offen nt lds
    s_add_u32 s8, s8, s76
    s_addc_u32 s9, s9, 0
    s_movk_i32 s48, 4608
    s_mov_b32 s49, 196608
    s_add_u32 s50, s49, s48
    s_lshl_b32 s51, s49, 1
    s_add_u32 s52, s51, s48
    s_add_u32 s100, s51, s49
    s_add_u32 s101, s100, s48
    s_cmp_eq_u32 s44, 2
    s_cbranch_scc1 L_stub
L_stubback:
    s_mov_b32 s14, 595968
    s_mov_b32 s15, 0x20000
    s_movk_i32 s22, 30720
    s_mov_b32 s23, 0x20000
    s_movk_i32 s38, 2560
    s_mov_b32 s39, 0x20000
    s_mov_b32 s35, 0x20000
    s_mul_i32 s74, s46, 160
    s_add_u32 s12, s12, s76
    s_addc_u32 s13, s13, 0
    s_mul_i32 s72, s45, 24
    s_mul_i32 s73, s44, 3
    s_add_u32 s72, s72, s73
    s_mul_i32 s72, s72, 0x2800
    s_add_u32 s72, s72, s74
    s_add_u32 s20, s20, s72
    s_addc_u32 s21, s21, 0
    s_and_b32 s72, s45, 3
    s_lshl_b32 s73, s72, 2
    s_lshl1_add_u32 s72, s72, 12
    s_cmp_lt_u32 s44, 4
    s_cselect_b32 s72, s73, s72
    s_lshr_b32 s73, s45, 2
    s_mul_i32 s73, s73, 24
    s_add_u32 s72, s72, s73
    s_add_u32 s72, s72, s44
    s_mov_b32 s75, s79
    s_mul_i32 s72, s72, 0x2800
    s_add_u32 s72, s72, s74
    s_add_u32 s32, s32, s72
    s_addc_u32 s33, s33, 0
    s_cmp_lt_u32 s44, 6
    s_cselect_b32 s34, 0x2800, 0
    s_lshl_b32 s78, s45, 16
    s_lshl_b32 s59, s46, 13
    s_add_u32 s59, s59, s78
    s_mul_i32 s79, s44, 96
    s_lshl_b32 s61, s44, 7
    s_add_u32 s61, s61, s78
    s_lshl1_add_u32 s54, s60, 51712
    s_bitset1_b32 s78, 12
    s_xor_b32 s57, s44, 4
    s_min_u32 s57, s57, 4
    s_lshl_b32 s60, s57, 10
    s_add_u32 s60, s60, s78
    s_lshl_b32 s72, s46, 7
    s_add_u32 s78, s78, s72
    s_bitset0_b32 s78, 16
    s_mov_b32 s62, 0x07060500
    s_or_b32 s63, s62, 1
    s_or_b32 s64, s62, 2
    s_or_b32 s65, s62, 3
    s_mov_b32 s66, 0x0c0c0400
    s_mov_b32 s67, 0x04000c0c
    s_mov_b32 s68, 0xffffff00
    s_bfe_u32 s99, s53, 0x30007
    s_movk_i32 s53, 0x5000
    s_getreg_b32 s3, hwreg(HW_REG_XCC_ID, 0, 4)
    s_lshl_b32 s72, s46, 2
    s_xor_b32 s72, s72, s45
    s_cselect_b32 s99, s99, 3
    s_cmp_eq_u32 s99, 3
    s_cselect_b32 s99, -1, 2
    s_xor_b32 s58, s44, 4
    s_or_b32 s58, s58, s72
    s_lshl_b32 s56, s46, 13
    s_add_u32 s56, s56, 2363392
    v_and_b32 v9, 1, v0
    v_lshlrev_b32 v9, 4, v9
    v_mov_b32 v26, 0xffff
    v_lshlrev_b32 v9, v9, v26
    v_lshrrev_b32 v26, 1, v10
    v_cmp_eq_u32 vcc, 0, v26
    v_cmp_eq_u32 s[70:71], 1, v26
    v_cmp_eq_u32 s[72:73], 2, v26
    v_cmp_eq_u32 s[76:77], 3, v26
    v_cndmask_b32 v4, 0, v9, vcc
    v_cndmask_b32 v5, 0, v9, s[70:71]
    v_cndmask_b32 v6, 0, v9, s[72:73]
    v_cndmask_b32 v7, 0, v9, s[76:77]
    v_lshlrev_b32 v24, 4, v24
    v_lshl_add_u32 v24, v2, 5, v24
    v_cmp_lt_u32 vcc, 9, v2
    v_mul_u32_u24 v20, 0x180, v3
    v_add_u32 v20, v20, v12
    v_lshl_add_u32 v21, v11, 3, v3
    v_mul_u32_u24 v21, 0x180, v21
    v_add_u32 v21, v21, v13
    v_mul_u32_u24 v1, 0xa00, v3
    v_cndmask_b32 v26, v12, v19, vcc
    v_lshl_add_u32 v2, v1, 1, v26
    v_add_u32 v1, v1, v26
    v_xor_b32 v9, v17, v3
    v_and_b32 v26, 2, v17
    v_and_or_b32 v9, v9, 1, v26
    v_lshl_add_u32 v9, v17, 2, v9
    v_and_b32 v26, 3, v0
    v_lshl_add_u32 v9, v9, 2, v26
    v_lshl_add_u32 v240, v9, 3, s75
    v_xor_b32 v241, 32, v240
    v_xor_b32 v242, 64, v240
    v_xor_b32 v243, 96, v240
    v_mul_u32_u24 v9, 0x420, v27
    v_xor_b32 v244, v9, v240
    v_xor_b32 v245, 64, v244
    v_and_b32 v28, 63, v0
    v_lshl_add_u32 v16, v28, 2, s75
    v_lshl_add_u32 v29, v17, 3, v26
    v_lshl_add_u32 v29, v29, 3, s75
    v_bfe_u32 v18, v0, 3, 3
    v_lshlrev_b32 v19, 7, v10
    v_lshl_add_u32 v19, v18, 4, v19
    v_lshlrev_b32 v28, 4, v28
    s_and_b32 s72, s45, 1
    s_cmp_lt_u32 s46, 6
    s_cselect_b32 s73, 10, 16
    s_cselect_b32 s76, 16, 10
    s_lshl_b32 s76, s72, s76
    s_lshl_b32 s72, s72, 10
    s_bitset1_b32 s72, 12
    v_cmp_lt_u32 vcc, 1, v3
    v_lshlrev_b32 v9, s73, v3
    v_lshl_add_u32 v9, v11, 11, v9
    v_add_u32 v9, s76, v9
    v_lshl_add_u32 v26, v11, 16, s72
    v_cndmask_b32 v9, v9, v26, vcc
    v_add_u32 v251, v9, v13
    v_lshl_add_u32 v14, v3, 3, v14
    s_lshl2_add_u32 s72, s46, s46
    s_add_u32 s72, s72, s44
    s_lshl_b32 s72, s72, 5
    s_add_u32 s72, s72, 51616
    v_and_b32 v30, 4, v0
    v_mul_u32_u24 v30, 320, v30
    v_lshl_add_u32 v30, v3, 3, v30
    v_add_u32 v30, s72, v30
    v_add_u32 v14, s54, v14
    v_mov_b32 v48, 0
    v_mov_b32 v52, 0
    v_mov_b64 v[246:247], 0
    v_mov_b64 v[248:249], 0
    s_cmp_lg_u32 s44, 0
    s_cbranch_scc1 L_noln
    s_waitcnt vmcnt(6)
    ds_write_b64 v15, v[200:201] offset:49152
    ds_write_b64 v15, v[202:203] offset:49160
    ds_write_b64 v15, v[204:205] offset:49168
    ds_write_b64 v15, v[206:207] offset:49176
    ds_write_b64 v15, v[208:209] offset:49184
    v_lshlrev_b32 v210, 16, v200
    v_and_b32 v211, 0xffff0000, v200
    v_lshlrev_b32 v212, 16, v201
    v_and_b32 v213, 0xffff0000, v201
    v_lshlrev_b32 v214, 16, v202
    v_and_b32 v215, 0xffff0000, v202
    v_lshlrev_b32 v216, 16, v203
    v_and_b32 v217, 0xffff0000, v203
    v_lshlrev_b32 v218, 16, v204
    v_and_b32 v219, 0xffff0000, v204
    v_lshlrev_b32 v220, 16, v205
    v_and_b32 v221, 0xffff0000, v205
    v_lshlrev_b32 v222, 16, v206
    v_and_b32 v223, 0xffff0000, v206
    v_lshlrev_b32 v224, 16, v207
    v_and_b32 v225, 0xffff0000, v207
    v_lshlrev_b32 v226, 16, v208
    v_and_b32 v227, 0xffff0000, v208
    v_lshlrev_b32 v228, 16, v209
    v_and_b32 v229, 0xffff0000, v209
    v_pk_add_f32 v[230:231], v[210:211], v[212:213]
    v_pk_add_f32 v[232:233], v[214:215], v[216:217]
    v_pk_add_f32 v[234:235], v[218:219], v[220:221]
    v_pk_add_f32 v[236:237], v[222:223], v[224:225]
    v_pk_add_f32 v[238:239], v[226:227], v[228:229]
    v_pk_add_f32 v[230:231], v[230:231], v[232:233]
    v_pk_add_f32 v[234:235], v[234:235], v[236:237]
    v_pk_add_f32 v[230:231], v[230:231], v[238:239]
    v_pk_add_f32 v[230:231], v[230:231], v[234:235]
    v_add_f32 v230, v230, v231
    s_nop 1
    v_add_f32_dpp v230, v230, v230 quad_perm:[1,0,3,2] row_mask:0xf bank_mask:0xf
    s_nop 1
    v_add_f32_dpp v230, v230, v230 quad_perm:[2,3,0,1] row_mask:0xf bank_mask:0xf
    s_nop 1
    v_add_f32_dpp v230, v230, v230 row_half_mirror row_mask:0xf bank_mask:0xf
    v_mov_b32 v231, v230
    s_nop 1
    v_permlane16_swap_b32 v231, v230
    v_add_f32 v230, v230, v231
    v_mov_b32 v231, v230
    s_nop 1
    v_permlane32_swap_b32 v231, v230
    v_add_f32 v230, v230, v231
    v_mul_f32 v230, 0x3acccccd, v230
    v_pk_add_f32 v[160:161], v[210:211], v[230:231] op_sel_hi:[1,0] neg_lo:[0,1] neg_hi:[0,1]
    v_pk_add_f32 v[162:163], v[212:213], v[230:231] op_sel_hi:[1,0] neg_lo:[0,1] neg_hi:[0,1]
    v_pk_add_f32 v[164:165], v[214:215], v[230:231] op_sel_hi:[1,0] neg_lo:[0,1] neg_hi:[0,1]
    v_pk_add_f32 v[166:167], v[216:217], v[230:231] op_sel_hi:[1,0] neg_lo:[0,1] neg_hi:[0,1]
    v_pk_add_f32 v[168:169], v[218:219], v[230:231] op_sel_hi:[1,0] neg_lo:[0,1] neg_hi:[0,1]
    v_pk_add_f32 v[170:171], v[220:221], v[230:231] op_sel_hi:[1,0] neg_lo:[0,1] neg_hi:[0,1]
    v_pk_add_f32 v[172:173], v[222:223], v[230:231] op_sel_hi:[1,0] neg_lo:[0,1] neg_hi:[0,1]
    v_pk_add_f32 v[174:175], v[224:225], v[230:231] op_sel_hi:[1,0] neg_lo:[0,1] neg_hi:[0,1]
    v_pk_add_f32 v[176:177], v[226:227], v[230:231] op_sel_hi:[1,0] neg_lo:[0,1] neg_hi:[0,1]
    v_pk_add_f32 v[178:179], v[228:229], v[230:231] op_sel_hi:[1,0] neg_lo:[0,1] neg_hi:[0,1]
    v_pk_mul_f32 v[232:233], v[160:161], v[160:161]
    v_pk_mul_f32 v[234:235], v[162:163], v[162:163]
    v_pk_fma_f32 v[232:233], v[164:165], v[164:165], v[232:233]
    v_pk_fma_f32 v[234:235], v[166:167], v[166:167], v[234:235]
    v_pk_fma_f32 v[232:233], v[168:169], v[168:169], v[232:233]
    v_pk_fma_f32 v[234:235], v[170:171], v[170:171], v[234:235]
    v_pk_fma_f32 v[232:233], v[172:173], v[172:173], v[232:233]
    v_pk_fma_f32 v[234:235], v[174:175], v[174:175], v[234:235]
    v_pk_fma_f32 v[232:233], v[176:177], v[176:177], v[232:233]
    v_pk_fma_f32 v[234:235], v[178:179], v[178:179], v[234:235]
    v_pk_add_f32 v[232:233], v[232:233], v[234:235]
    v_add_f32 v232, v232, v233
    s_nop 1
    v_add_f32_dpp v232, v232, v232 quad_perm:[1,0,3,2] row_mask:0xf bank_mask:0xf
    s_nop 1
    v_add_f32_dpp v232, v232, v232 quad_perm:[2,3,0,1] row_mask:0xf bank_mask:0xf
    s_nop 1
    v_add_f32_dpp v232, v232, v232 row_half_mirror row_mask:0xf bank_mask:0xf
    v_mov_b32 v233, v232
    s_nop 1
    v_permlane16_swap_b32 v233, v232
    v_add_f32 v232, v232, v233
    v_mov_b32 v233, v232
    s_nop 1
    v_permlane32_swap_b32 v233, v232
    v_add_f32 v232, v232, v233
    v_mul_f32 v232, 0x3acccccd, v232
    v_cvt_pk_bf16_f32 v230, v230, v232
    v_and_b32 v231, 0xffff0000, v230
    v_lshlrev_b32 v230, 16, v230
    v_add_f32 v231, 0x3727c5ac, v231
    v_cvt_pk_bf16_f32 v231, v231, v231
    v_and_b32 v231, 0xffff0000, v231
    v_sqrt_f32 v231, v231
    s_nop 0
    v_cvt_pk_bf16_f32 v231, v231, v231
    v_and_b32 v231, 0xffff0000, v231
    v_rcp_f32 v231, v231
    s_nop 0
    v_pk_add_f32 v[210:211], v[210:211], v[230:231] op_sel_hi:[1,0] neg_lo:[0,1] neg_hi:[0,1]
    v_pk_add_f32 v[212:213], v[212:213], v[230:231] op_sel_hi:[1,0] neg_lo:[0,1] neg_hi:[0,1]
    v_pk_add_f32 v[214:215], v[214:215], v[230:231] op_sel_hi:[1,0] neg_lo:[0,1] neg_hi:[0,1]
    v_pk_add_f32 v[216:217], v[216:217], v[230:231] op_sel_hi:[1,0] neg_lo:[0,1] neg_hi:[0,1]
    v_pk_add_f32 v[218:219], v[218:219], v[230:231] op_sel_hi:[1,0] neg_lo:[0,1] neg_hi:[0,1]
    v_pk_add_f32 v[220:221], v[220:221], v[230:231] op_sel_hi:[1,0] neg_lo:[0,1] neg_hi:[0,1]
    v_pk_add_f32 v[222:223], v[222:223], v[230:231] op_sel_hi:[1,0] neg_lo:[0,1] neg_hi:[0,1]
    v_pk_add_f32 v[224:225], v[224:225], v[230:231] op_sel_hi:[1,0] neg_lo:[0,1] neg_hi:[0,1]
    v_pk_add_f32 v[226:227], v[226:227], v[230:231] op_sel_hi:[1,0] neg_lo:[0,1] neg_hi:[0,1]
    v_pk_add_f32 v[228:229], v[228:229], v[230:231] op_sel_hi:[1,0] neg_lo:[0,1] neg_hi:[0,1]
    v_cvt_pk_bf16_f32 v210, 0, v210
    v_cvt_pk_bf16_f32 v211, 0, v211
    v_cvt_pk_bf16_f32 v212, 0, v212
    v_cvt_pk_bf16_f32 v213, 0, v213
    v_cvt_pk_bf16_f32 v214, 0, v214
    v_cvt_pk_bf16_f32 v215, 0, v215
    v_cvt_pk_bf16_f32 v216, 0, v216
    v_cvt_pk_bf16_f32 v217, 0, v217
    v_cvt_pk_bf16_f32 v218, 0, v218
    v_cvt_pk_bf16_f32 v219, 0, v219
    v_cvt_pk_bf16_f32 v220, 0, v220
    v_cvt_pk_bf16_f32 v221, 0, v221
    v_cvt_pk_bf16_f32 v222, 0, v222
    v_cvt_pk_bf16_f32 v223, 0, v223
    v_cvt_pk_bf16_f32 v224, 0, v224
    v_cvt_pk_bf16_f32 v225, 0, v225
    v_cvt_pk_bf16_f32 v226, 0, v226
    v_cvt_pk_bf16_f32 v227, 0, v227
    v_cvt_pk_bf16_f32 v228, 0, v228
    v_cvt_pk_bf16_f32 v229, 0, v229
    v_pk_mul_f32 v[210:211], v[210:211], v[230:231] op_sel:[0,1] op_sel_hi:[1,1]
    v_pk_mul_f32 v[212:213], v[212:213], v[230:231] op_sel:[0,1] op_sel_hi:[1,1]
    v_pk_mul_f32 v[214:215], v[214:215], v[230:231] op_sel:[0,1] op_sel_hi:[1,1]
    v_pk_mul_f32 v[216:217], v[216:217], v[230:231] op_sel:[0,1] op_sel_hi:[1,1]
    v_pk_mul_f32 v[218:219], v[218:219], v[230:231] op_sel:[0,1] op_sel_hi:[1,1]
    v_pk_mul_f32 v[220:221], v[220:221], v[230:231] op_sel:[0,1] op_sel_hi:[1,1]
    v_pk_mul_f32 v[222:223], v[222:223], v[230:231] op_sel:[0,1] op_sel_hi:[1,1]
    v_pk_mul_f32 v[224:225], v[224:225], v[230:231] op_sel:[0,1] op_sel_hi:[1,1]
    v_pk_mul_f32 v[226:227], v[226:227], v[230:231] op_sel:[0,1] op_sel_hi:[1,1]
    v_pk_mul_f32 v[228:229], v[228:229], v[230:231] op_sel:[0,1] op_sel_hi:[1,1]
    v_cvt_pk_bf16_f32 v160, v210, v211
    v_cvt_pk_bf16_f32 v161, v212, v213
    v_cvt_pk_bf16_f32 v162, v214, v215
    v_cvt_pk_bf16_f32 v163, v216, v217
    v_cvt_pk_bf16_f32 v164, v218, v219
    v_cvt_pk_bf16_f32 v165, v220, v221
    v_cvt_pk_bf16_f32 v166, v222, v223
    v_cvt_pk_bf16_f32 v167, v224, v225
    v_cvt_pk_bf16_f32 v168, v226, v227
    v_cvt_pk_bf16_f32 v169, v228, v229
    ds_write_b64 v15, v[160:161] offset:51712
    ds_write_b64 v15, v[162:163] offset:51720
    ds_write_b64 v15, v[164:165] offset:51728
    ds_write_b64 v15, v[166:167] offset:51736
    ds_write_b64 v15, v[168:169] offset:51744
    s_waitcnt vmcnt(5)
    v_add_u32 v8, 0x3b5d7f1d, v8
    ds_write_b32 v25, v8 offset:55808
    s_waitcnt lgkmcnt(0)
L_noln:
    s_waitcnt vmcnt(4)
    buffer_load_dwordx4 v[64:67], v22, s[8:11], 0 offen offset:0 nt
    s_waitcnt vmcnt(4)
    buffer_load_dwordx4 v[68:71], v22, s[8:11], 0 offen offset:1536 nt
    s_waitcnt vmcnt(4)
    buffer_load_dwordx4 v[72:75], v23, s[8:11], 0 offen offset:256 nt
    s_waitcnt vmcnt(4)
    buffer_load_dwordx4 v[76:79], v22, s[8:11], 0 offen offset:3072 nt
    s_waitcnt vmcnt(4)
    buffer_load_dwordx4 v[80:83], v22, s[8:11], s48 offen offset:0 nt
    s_barrier
    ds_read2_b64 v[160:163], v14 offset1:4
    ds_read_b64_tr_b16 v[168:169], v240 offset:0
    ds_read_b64_tr_b16 v[170:171], v240 offset:2048
    ds_read_b64_tr_b16 v[172:173], v241 offset:0
    ds_read_b64_tr_b16 v[174:175], v241 offset:2048
    ds_read_b64_tr_b16 v[176:177], v242 offset:0
    ds_read_b64_tr_b16 v[178:179], v242 offset:2048
    ds_read_b64_tr_b16 v[180:181], v243 offset:0
    ds_read_b64_tr_b16 v[182:183], v243 offset:2048
    s_mov_b32 exec_hi, 0
    ds_read_b64 v[246:247], v14 offset:64
    s_not_b64 exec, exec
    ds_read_b64 v[248:249], v14 offset:48
    s_mov_b32 exec_lo, -1
    ds_read_b64_tr_b16 v[184:185], v244 offset:4096
    ds_read_b64_tr_b16 v[186:187], v245 offset:4096
    ds_read_b32 v8, v25 offset:55808
    s_cmp_lt_u32 s44, 3
    s_cbranch_scc1 L_nom1
    ds_read_b64 v[192:193], v30
    ds_read_b64_tr_b16 v[196:197], v29 offset:5120
    ds_read_b64_tr_b16 v[198:199], v29 offset:5152
    s_waitcnt lgkmcnt(0)
    v_mfma_f32_16x16x16_bf16 v[48:51], v[192:193], v[196:197], 0
    v_mfma_f32_16x16x16_bf16 v[52:55], v[192:193], v[198:199], 0
L_nom1:
    s_waitcnt lgkmcnt(0)
    v_mfma_f32_16x16x32_bf16 v[32:35], v[160:163], v[168:171], 0
    v_mfma_f32_16x16x32_bf16 v[36:39], v[160:163], v[172:175], 0
    v_mfma_f32_16x16x32_bf16 v[40:43], v[160:163], v[176:179], 0
    v_mfma_f32_16x16x32_bf16 v[44:47], v[160:163], v[180:183], 0
    v_mfma_f32_16x16x16_bf16 v[32:35], v[246:247], v[184:185], v[32:35]
    v_mfma_f32_16x16x16_bf16 v[36:39], v[248:249], v[184:185], v[36:39]
    v_mfma_f32_16x16x16_bf16 v[40:43], v[246:247], v[186:187], v[40:43]
    v_mfma_f32_16x16x16_bf16 v[44:47], v[248:249], v[186:187], v[44:47]
    buffer_load_dwordx4 v[84:87], v23, s[8:11], 0 offen offset:3328 nt
    v_mov_b32_dpp v48, v52 quad_perm:[0,1,2,3] row_mask:0xc bank_mask:0xf
    ds_write_b32 v16, v48 offset:512
    s_nop 2
    v_mov_b32_dpp v32, v36 quad_perm:[0,1,2,3] row_mask:0xa bank_mask:0xf
    s_nop 0
    v_mov_b32_dpp v40, v44 quad_perm:[0,1,2,3] row_mask:0xa bank_mask:0xf
    ds_write2st64_b32 v16, v32, v40 offset1:1
    s_waitcnt lgkmcnt(0)
    s_barrier
    s_waitcnt vmcnt(4)
    buffer_load_dwordx4 v[88:91], v22, s[8:11], s49 offen offset:0 nt
    s_waitcnt vmcnt(4)
    buffer_load_dwordx4 v[92:95], v22, s[8:11], s49 offen offset:1536 nt
    s_cmp_lg_u32 s44, 1
    s_cbranch_scc1 L_nopub
    v_xor_b32 v9, s3, v8
    ds_read_b128 v[160:163], v28 offset:0
    ds_read_b128 v[164:167], v28 offset:6144
    ds_read_b128 v[168:171], v28 offset:12288
    ds_read_b128 v[172:175], v28 offset:18432
    ds_read_b128 v[176:179], v28 offset:24576
    ds_read_b128 v[180:183], v28 offset:30720
    ds_read_b128 v[184:187], v28 offset:36864
    ds_read_b128 v[188:191], v28 offset:43008
    s_waitcnt lgkmcnt(0)
    v_pk_add_f32 v[160:161], v[160:161], v[164:165]
    v_pk_add_f32 v[162:163], v[162:163], v[166:167]
    v_pk_add_f32 v[168:169], v[168:169], v[172:173]
    v_pk_add_f32 v[170:171], v[170:171], v[174:175]
    v_pk_add_f32 v[176:177], v[176:177], v[180:181]
    v_pk_add_f32 v[178:179], v[178:179], v[182:183]
    v_pk_add_f32 v[184:185], v[184:185], v[188:189]
    v_pk_add_f32 v[186:187], v[186:187], v[190:191]
    v_pk_add_f32 v[160:161], v[160:161], v[168:169]
    v_pk_add_f32 v[162:163], v[162:163], v[170:171]
    v_pk_add_f32 v[176:177], v[176:177], v[184:185]
    v_pk_add_f32 v[178:179], v[178:179], v[186:187]
    v_pk_add_f32 v[160:161], v[160:161], v[176:177]
    v_pk_add_f32 v[162:163], v[162:163], v[178:179]
    v_perm_b32 v252, v160, v9, s62
    v_perm_b32 v253, v161, v9, s63
    v_perm_b32 v254, v162, v9, s64
    v_perm_b32 v255, v163, v9, s65
    s_mov_b32 exec_hi, 0xffff
    buffer_store_dwordx4 v[252:255], v251, s[40:43], s78 offen
    s_mov_b32 exec_hi, -1
L_nopub:
    s_cmp_eq_u32 s58, 0
    s_cbranch_scc1 L_init
L_initd:
    v_mov_b64 v[32:33], 0
    v_mov_b64 v[34:35], 0
    v_mov_b64 v[36:37], 0
    v_mov_b64 v[38:39], 0
    v_mov_b64 v[40:41], 0
    v_mov_b64 v[42:43], 0
    v_mov_b64 v[44:45], 0
    v_mov_b64 v[46:47], 0
    v_mov_b64 v[48:49], 0
    v_mov_b64 v[50:51], 0
    v_mov_b64 v[52:53], 0
    v_mov_b64 v[54:55], 0
    s_mul_i32 s72, s57, 0x140
    s_and_b32 s72, s72, 0x640
    s_add_u32 s72, s72, 54272
    s_cmp_lt_u32 s57, 4
    s_cselect_b32 s73, 6, 0
    s_cselect_b32 s74, 0, 1
    v_xor_b32 v9, s44, v27
    v_and_b32 v9, s74, v9
    v_and_or_b32 v14, v10, s73, v9
    v_lshl_add_u32 v250, v9, 10, v19
    v_lshlrev_b32 v14, 6, v14
    v_lshl_add_u32 v14, v18, 3, v14
    v_add_u32 v14, s72, v14
    s_lshl_b32 s72, s47, 9
    v_and_b32 v9, 3, v0
    v_lshl_add_u32 v12, v3, 2, v9
    v_lshlrev_b32 v12, 4, v12
    v_and_b32 v13, 0x70, v12
    v_add_u32 v12, s72, v12
    v_add_u32 v13, s72, v13
    s_mov_b32 s69, 0
    s_mul_i32 s72, s44, 1632
    v_mul_u32_u24 v16, 816, v27
    v_add3_u32 v16, v16, v24, s72
    v_lshlrev_b32 v17, 8, v11
    v_sub_u32 v17, v16, v17
    v_lshl_add_u32 v26, v11, 2, v9
    v_lshlrev_b32 v26, 13, v26
    v_and_b32 v25, 4, v0
    v_cmp_ne_u32 vcc, 0, v25
    v_add_u32 v9, 4, v27
    s_lshl_b32 s75, s47, 5
    v_cndmask_b32 v9, v3, v9, vcc
    v_lshl_add_u32 v25, v9, 4, v26
    s_add_u32 s75, s75, s45
    s_lshl_b32 s75, s75, 12
    s_add_u32 s75, s75, 2097152
    s_and_b32 s74, s46, 3
    s_lshl_b32 s74, s74, 3
    s_add_u32 s74, s74, s44
    s_lshl_b32 s74, s74, 4
    s_add_u32 s74, s74, s75
    v_and_b32 v26, 31, v0
    v_lshlrev_b32 v26, 4, v26
    s_lshl_b32 s72, s44, 4
    s_cmp_lt_u32 s44, 4
    s_cselect_b32 s73, 9, 5
    v_lshlrev_b32 v28, s73, v11
    s_cselect_b32 s73, 0, 576
    s_add_u32 s72, s72, s73
    s_add_u32 s72, s72, 54656
    v_lshl_add_u32 v28, v3, 2, v28
    v_add_u32 v28, s72, v28
    s_mul_i32 s72, s44, 1024
    s_add_u32 s72, s72, 22528
    v_lshl_add_u32 v29, v27, 9, v24
    v_add_u32 v29, s72, v29
    s_lshl_b32 s72, s44, 7
    v_lshl_add_u32 v31, v18, 4, s72
    v_cmp_lt_u32 vcc, 319, v31
    v_mul_u32_u24 v30, 1024, v10
    v_mov_b32 v9, 192
    v_cndmask_b32 v9, 0, v9, vcc
    v_add3_u32 v30, v30, v31, v9
    v_lshl_add_u32 v9, v18, 4, s79
    v_mul_u32_u24 v3, 1632, v10
    v_add_u32 v3, v3, v9
    s_waitcnt vmcnt(3)
    s_bitcmp1_b32 s99, s44
    s_cbranch_scc1 L_cw13_2
    s_waitcnt vmcnt(2)
L_cw13_2:
    buffer_load_dwordx4 v[96:99], v23, s[8:11], s49 offen offset:256 nt
    s_waitcnt vmcnt(3)
    s_cbranch_scc1 L_cw14_2
    s_waitcnt vmcnt(2)
L_cw14_2:
    buffer_load_dwordx4 v[100:103], v22, s[8:11], s49 offen offset:3072 nt
    s_waitcnt vmcnt(3)
    s_cbranch_scc1 L_cw15_2
    s_waitcnt vmcnt(2)
L_cw15_2:
    buffer_load_dwordx4 v[104:107], v22, s[8:11], s50 offen offset:0 nt
    s_waitcnt vmcnt(3)
    s_bitcmp1_b32 s99, 0
    s_cbranch_scc1 L_cw16_2
    s_waitcnt vmcnt(2)
L_cw16_2:
    buffer_load_dwordx4 v[108:111], v23, s[8:11], s49 offen offset:3328 nt
    s_waitcnt vmcnt(3)
    s_cbranch_scc1 L_cw17_2
    s_waitcnt vmcnt(2)
L_cw17_2:
    buffer_load_dwordx4 v[112:115], v22, s[8:11], s51 offen offset:0 nt
    s_waitcnt vmcnt(3)
    s_cbranch_scc1 L_cw18_2
    s_waitcnt vmcnt(2)
L_cw18_2:
    buffer_load_dwordx4 v[116:119], v22, s[8:11], s51 offen offset:1536 nt
    s_waitcnt vmcnt(3)
    s_cbranch_scc1 L_cw19_2
    s_waitcnt vmcnt(2)
L_cw19_2:
    buffer_load_dwordx4 v[120:123], v23, s[8:11], s51 offen offset:256 nt
    s_waitcnt vmcnt(3)
    s_cbranch_scc1 L_cw20_2
    s_waitcnt vmcnt(2)
L_cw20_2:
    buffer_load_dwordx4 v[124:127], v22, s[8:11], s51 offen offset:3072 nt
    buffer_load_dwordx4 v[56:59], v250, s[40:43], s60 offen sc1 nt
    s_waitcnt vmcnt(4)
    s_cbranch_scc1 L_cw22_3
    s_waitcnt vmcnt(3)
L_cw22_3:
    buffer_load_dwordx4 v[128:131], v22, s[8:11], s52 offen offset:0 nt
    s_waitcnt vmcnt(4)
    s_cbranch_scc1 L_cw23_3
    s_waitcnt vmcnt(3)
L_cw23_3:
    buffer_load_dwordx4 v[132:135], v23, s[8:11], s51 offen offset:3328 nt
    buffer_load_dwordx4 v[136:139], v22, s[8:11], s100 offen offset:0 nt
    buffer_load_dwordx4 v[140:143], v22, s[8:11], s100 offen offset:1536 nt
    s_waitcnt vmcnt(5)
    buffer_load_dwordx4 v[144:147], v23, s[8:11], s100 offen offset:256 nt
    s_waitcnt vmcnt(4)
    buffer_load_dwordx4 v[148:151], v22, s[8:11], s100 offen offset:3072 nt
L_qchk:
    v_perm_b32 v9, v57, v56, s66
    v_perm_b32 v10, v59, v58, s67
    v_or_b32 v9, v9, v10
    v_xor_b32 v9, v9, v8
    v_cmp_lt_u32 vcc, 15, v9
    s_cbranch_vccz L_qok
    s_branch L_qsl
.p2align 12
L_stub:
    s_branch L_stubback
L_qok:
    s_mov_b64 exec, -1
    v_cmp_ne_u32 s[70:71], s3, v9
    v_and_b32 v56, s68, v56
    v_and_b32 v57, s68, v57
    v_and_b32 v58, s68, v58
    v_and_b32 v59, s68, v59
    s_cmp_gt_u32 s44, 3
    v_add_f32_dpp v56, v56, v56 quad_perm:[1,0,3,2] row_mask:0xf bank_mask:0xf
    v_add_f32_dpp v57, v57, v57 quad_perm:[1,0,3,2] row_mask:0xf bank_mask:0xf
    v_add_f32_dpp v58, v58, v58 quad_perm:[1,0,3,2] row_mask:0xf bank_mask:0xf
    v_add_f32_dpp v59, v59, v59 quad_perm:[1,0,3,2] row_mask:0xf bank_mask:0xf
    s_cbranch_scc1 L_nosum
    ds_write_b32 v250, v9 offset:56320
    v_add_f32_dpp v56, v56, v56 quad_perm:[2,3,0,1] row_mask:0xf bank_mask:0xf
    v_add_f32_dpp v57, v57, v57 quad_perm:[2,3,0,1] row_mask:0xf bank_mask:0xf
    v_add_f32_dpp v58, v58, v58 quad_perm:[2,3,0,1] row_mask:0xf bank_mask:0xf
    v_add_f32_dpp v59, v59, v59 quad_perm:[2,3,0,1] row_mask:0xf bank_mask:0xf
    v_add_f32_dpp v56, v56, v56 row_half_mirror row_mask:0xf bank_mask:0xf
    v_add_f32_dpp v57, v57, v57 row_half_mirror row_mask:0xf bank_mask:0xf
    v_add_f32_dpp v58, v58, v58 row_half_mirror row_mask:0xf bank_mask:0xf
    v_add_f32_dpp v59, v59, v59 row_half_mirror row_mask:0xf bank_mask:0xf
L_nosum:
    v_cvt_pk_bf16_f32 v56, v56, v57
    v_cvt_pk_bf16_f32 v57, v58, v59
    ds_write_b64 v14, v[56:57]
    s_cmp_lg_u64 s[70:71], 0
    s_cbranch_scc1 L_qre2
L_qre2d:
    buffer_load_dwordx4 v[152:155], v22, s[8:11], s101 offen offset:0 nt
    s_cmp_eq_u32 s58, 0
    s_cbranch_scc1 L_flag
L_flagd:
    s_add_u32 s58, s56, 4096
    s_waitcnt lgkmcnt(0)
    s_barrier
    s_mov_b32 exec_lo, 0x000f000f
    s_mov_b32 exec_hi, 0x000f000f
    ds_read_b128 v[32:35], v12 offset:54272
    s_mov_b32 exec_lo, 0x00f000f0
    s_mov_b32 exec_hi, 0x00f000f0
    ds_read_b128 v[36:39], v12 offset:54272
    s_mov_b32 exec_lo, 0x0f000f00
    s_mov_b32 exec_hi, 0x0f000f00
    ds_read_b128 v[40:43], v12 offset:54272
    s_mov_b32 exec_lo, 0xf000f000
    s_mov_b32 exec_hi, 0xf000f000
    ds_read_b128 v[44:47], v12 offset:54272
    s_mov_b32 exec_lo, 0x000f000f
    s_mov_b32 exec_hi, 0x00f000f0
    ds_read_b128 v[48:51], v13 offset:54528
    s_mov_b32 exec_lo, 0x0f000f00
    s_mov_b32 exec_hi, 0xf000f000
    ds_read_b128 v[52:55], v13 offset:54528
    s_mov_b64 exec, -1
    ds_read_b32 v14, v28
    ds_read_b32 v15, v28 offset:64
    v_lshl_add_u32 v9, v27, 10, v19
    ds_read_b32 v9, v9 offset:56320
    s_waitcnt lgkmcnt(0)
    v_mfma_f32_16x16x32_bf16 v[56:59], v[64:67], v[32:35], 0
    v_mfma_f32_16x16x32_bf16 v[60:63], v[88:91], v[32:35], 0
    v_mfma_f32_16x16x32_bf16 v[56:59], v[68:71], v[36:39], v[56:59]
    v_mfma_f32_16x16x32_bf16 v[60:63], v[92:95], v[36:39], v[60:63]
    v_mfma_f32_16x16x32_bf16 v[56:59], v[72:75], v[48:51], v[56:59]
    v_mfma_f32_16x16x32_bf16 v[60:63], v[96:99], v[48:51], v[60:63]
    v_mfma_f32_16x16x32_bf16 v[56:59], v[76:79], v[40:43], v[56:59]
    v_mfma_f32_16x16x32_bf16 v[60:63], v[100:103], v[40:43], v[60:63]
    v_mfma_f32_16x16x32_bf16 v[56:59], v[80:83], v[44:47], v[56:59]
    v_mfma_f32_16x16x32_bf16 v[60:63], v[104:107], v[44:47], v[60:63]
    v_mfma_f32_16x16x32_bf16 v[56:59], v[84:87], v[52:55], v[56:59]
    v_mfma_f32_16x16x32_bf16 v[60:63], v[108:111], v[52:55], v[60:63]
    v_cmp_ne_u32 s[70:71], s3, v9
    s_cmp_lt_u32 s44, 6
    s_cselect_b32 s72, -1, 0
    v_and_b32 v14, s72, v14
    v_and_b32 v15, s72, v15
    v_lshlrev_b32 v10, 16, v14
    v_and_b32 v11, 0xffff0000, v14
    v_lshlrev_b32 v12, 16, v15
    v_and_b32 v13, 0xffff0000, v15
    v_mov_b32 v9, 0xc0135761
    s_mov_b32 s72, 0xbdd2d3e8
    v_mul_f32 v14, v10, v10
    v_mul_f32 v15, v11, v11
    v_fma_f32 v14, v14, s72, v9
    v_fma_f32 v15, v15, s72, v9
    v_mul_f32 v14, v14, v10
    v_mul_f32 v15, v15, v11
    v_exp_f32 v14, v14
    v_exp_f32 v15, v15
    v_add_f32 v14, 1.0, v14
    v_add_f32 v15, 1.0, v15
    v_rcp_f32 v14, v14
    v_rcp_f32 v15, v15
    v_mul_f32 v14, v14, v10
    v_mul_f32 v15, v15, v11
    v_cvt_pk_bf16_f32 v15, v14, v15
    v_lshlrev_b32 v14, 16, v15
    v_and_b32 v15, 0xffff0000, v15
    v_mul_f32 v14, v14, v12
    v_mul_f32 v15, v15, v13
    v_cvt_pk_bf16_f32 v14, v14, v14
    v_cvt_pk_bf16_f32 v15, v15, v15
    s_waitcnt vmcnt(4)
    buffer_load_dwordx4 v[156:159], v23, s[8:11], s100 offen offset:3328 nt
    v_mfma_f32_16x16x32_bf16 v[64:67], v[112:115], v[32:35], 0
    v_mfma_f32_16x16x32_bf16 v[64:67], v[116:119], v[36:39], v[64:67]
    v_mfma_f32_16x16x32_bf16 v[64:67], v[120:123], v[48:51], v[64:67]
    v_mfma_f32_16x16x32_bf16 v[64:67], v[124:127], v[40:43], v[64:67]
    v_mfma_f32_16x16x32_bf16 v[64:67], v[128:131], v[44:47], v[64:67]
    v_mfma_f32_16x16x32_bf16 v[64:67], v[132:135], v[52:55], v[64:67]
    s_waitcnt vmcnt(4)
    buffer_load_dwordx4 v[160:163], v20, s[12:15], 0 offen offset:0 nt
    s_waitcnt vmcnt(4)
    buffer_load_dwordx4 v[164:167], v20, s[12:15], 0 offen offset:3072 nt
    s_waitcnt vmcnt(4)
    buffer_load_dwordx4 v[168:171], v21, s[12:15], 0 offen offset:256 nt
    s_waitcnt vmcnt(4)
    buffer_load_dwordx4 v[172:175], v20, s[12:15], 0 offen offset:1536 nt
    s_waitcnt vmcnt(4)
    buffer_load_dwordx4 v[176:179], v20, s[12:15], s48 offen offset:0 nt
    v_mfma_f32_16x16x32_bf16 v[68:71], v[136:139], v[32:35], 0
    v_mfma_f32_16x16x32_bf16 v[68:71], v[140:143], v[36:39], v[68:71]
    v_mfma_f32_16x16x32_bf16 v[68:71], v[144:147], v[48:51], v[68:71]
    v_mfma_f32_16x16x32_bf16 v[68:71], v[148:151], v[40:43], v[68:71]
    v_mfma_f32_16x16x32_bf16 v[68:71], v[152:155], v[44:47], v[68:71]
    v_mfma_f32_16x16x32_bf16 v[68:71], v[156:159], v[52:55], v[68:71]
    v_mov_b32_dpp v32, v56 quad_perm:[0,0,0,0] row_mask:0xf bank_mask:0xf
    v_mov_b32_dpp v33, v60 quad_perm:[0,0,0,0] row_mask:0xf bank_mask:0xf
    v_mov_b32_dpp v34, v64 quad_perm:[0,0,0,0] row_mask:0xf bank_mask:0xf
    s_nop 4
    v_mov_b32_dpp v35, v68 quad_perm:[0,0,0,0] row_mask:0xf bank_mask:0xf
    v_add_f32_dpp v32, v57, v32 quad_perm:[1,1,1,1] row_mask:0xf bank_mask:0xf
    v_add_f32_dpp v33, v61, v33 quad_perm:[1,1,1,1] row_mask:0xf bank_mask:0xf
    v_add_f32_dpp v34, v65, v34 quad_perm:[1,1,1,1] row_mask:0xf bank_mask:0xf
    v_add_f32_dpp v35, v69, v35 quad_perm:[1,1,1,1] row_mask:0xf bank_mask:0xf
    v_add_f32_dpp v32, v58, v32 quad_perm:[2,2,2,2] row_mask:0xf bank_mask:0xf
    v_add_f32_dpp v33, v62, v33 quad_perm:[2,2,2,2] row_mask:0xf bank_mask:0xf
    v_add_f32_dpp v34, v66, v34 quad_perm:[2,2,2,2] row_mask:0xf bank_mask:0xf
    v_add_f32_dpp v35, v70, v35 quad_perm:[2,2,2,2] row_mask:0xf bank_mask:0xf
    v_add_f32_dpp v32, v59, v32 quad_perm:[3,3,3,3] row_mask:0xf bank_mask:0xf
    v_add_f32_dpp v33, v63, v33 quad_perm:[3,3,3,3] row_mask:0xf bank_mask:0xf
    v_add_f32_dpp v34, v67, v34 quad_perm:[3,3,3,3] row_mask:0xf bank_mask:0xf
    v_add_f32_dpp v35, v71, v35 quad_perm:[3,3,3,3] row_mask:0xf bank_mask:0xf
    v_cvt_pk_bf16_f32 v33, v32, v33
    v_cvt_pk_bf16_f32 v35, v34, v35
    v_lshlrev_b32 v32, 16, v33
    v_and_b32 v33, 0xffff0000, v33
    v_lshlrev_b32 v34, 16, v35
    v_and_b32 v35, 0xffff0000, v35
    v_mul_f32 v32, 0x3d93cd3a, v32
    v_mul_f32 v33, 0x3d93cd3a, v33
    v_mul_f32 v34, 0x3d93cd3a, v34
    v_mul_f32 v35, 0x3d93cd3a, v35
    v_cvt_pk_bf16_f32 v33, v32, v33
    v_cvt_pk_bf16_f32 v35, v34, v35
    v_lshlrev_b32 v32, 16, v33
    v_and_b32 v33, 0xffff0000, v33
    v_lshlrev_b32 v34, 16, v35
    v_and_b32 v35, 0xffff0000, v35
    v_max3_f32 v36, v32, v33, v34
    v_max_f32 v36, v36, v35
    s_nop 1
    v_max_f32_dpp v36, v36, v36 row_ror:4 row_mask:0xf bank_mask:0xf
    s_nop 1
    v_max_f32_dpp v36, v36, v36 row_ror:8 row_mask:0xf bank_mask:0xf
    v_mov_b32 v37, v36
    s_nop 1
    v_permlane16_swap_b32 v37, v36
    v_max_f32 v36, v36, v37
    v_mov_b32 v37, v36
    s_nop 1
    v_permlane32_swap_b32 v37, v36
    v_max_f32 v36, v36, v37
    s_mov_b32 s73, 0x3fb8aa3b
    v_mul_f32 v44, s73, v36
    v_fma_f32 v32, v32, s73, -v44
    v_fma_f32 v33, v33, s73, -v44
    v_fma_f32 v34, v34, s73, -v44
    v_fma_f32 v35, v35, s73, -v44
    v_exp_f32 v32, v32
    v_exp_f32 v33, v33
    v_exp_f32 v34, v34
    v_exp_f32 v35, v35
    s_waitcnt vmcnt(4)
    buffer_load_dwordx4 v[180:183], v21, s[12:15], 0 offen offset:1792 nt
    v_add_f32 v37, v32, v33
    v_add_f32 v38, v34, v35
    v_add_f32 v37, v37, v38
    v_lshlrev_b32 v45, 5, v26
    s_nop 0
    v_add_f32_dpp v37, v37, v37 row_ror:4 row_mask:0xf bank_mask:0xf
    v_and_b32 v120, v14, v4
    v_and_b32 v124, v15, v4
    v_add_f32_dpp v37, v37, v37 row_ror:8 row_mask:0xf bank_mask:0xf
    v_and_b32 v121, v14, v5
    v_and_b32 v125, v15, v5
    v_mov_b32 v38, v37
    v_and_b32 v122, v14, v6
    v_and_b32 v126, v15, v6
    v_permlane16_swap_b32 v38, v37
    v_add_f32 v37, v37, v38
    v_mov_b32 v38, v37
    v_and_b32 v123, v14, v7
    v_and_b32 v127, v15, v7
    v_permlane32_swap_b32 v38, v37
    v_add_f32 v37, v37, v38
    v_perm_b32 v36, v36, v8, s62
    v_perm_b32 v37, v37, v8, s63
    v_perm_b32 v38, v38, v8, s64
    v_perm_b32 v39, v39, v8, s65
    s_cmp_lg_u64 s[70:71], 0
    s_mov_b64 exec, 1
    s_cbranch_scc1 L_slow_m
    buffer_store_dwordx4 v[36:39], v45, s[40:43], s74 offen
L_back_m:
    s_mov_b64 exec, -1
    s_mov_b32 s69, 0
    s_movk_i32 s77, 0x101
    s_mov_b32 s76, 0x01010101
    s_mov_b32 s54, 0xffff0000
    s_mov_b32 s55, 0xffff0000
    s_waitcnt vmcnt(3)
    s_bitcmp1_b32 s99, 0
    s_cbranch_scc1 L_cw36_2
    s_waitcnt vmcnt(2)
L_cw36_2:
    buffer_load_dwordx4 v[184:187], v20, s[12:15], s49 offen offset:0 nt
    s_waitcnt vmcnt(3)
    s_cbranch_scc1 L_cw37_2
    s_waitcnt vmcnt(2)
L_cw37_2:
    buffer_load_dwordx4 v[188:191], v20, s[12:15], s49 offen offset:3072 nt
    s_waitcnt vmcnt(3)
    s_cbranch_scc1 L_cw38_2
    s_waitcnt vmcnt(2)
L_cw38_2:
    buffer_load_dwordx4 v[128:131], v1, s[32:35], 0 offen offset:0 nt
    s_waitcnt vmcnt(3)
    s_cbranch_scc1 L_cw39_2
    s_waitcnt vmcnt(2)
L_cw39_2:
    buffer_load_dwordx4 v[132:135], v1, s[32:35], 0 offen offset:1280 nt
    s_waitcnt vmcnt(3)
    s_cbranch_scc1 L_cw40_2
    s_waitcnt vmcnt(2)
L_cw40_2:
    buffer_load_dwordx4 v[136:139], v2, s[20:23], 0 offen offset:0 nt
    s_waitcnt vmcnt(3)
    s_cbranch_scc1 L_cw41_2
    s_waitcnt vmcnt(2)
L_cw41_2:
    buffer_load_dwordx4 v[192:195], v21, s[12:15], s49 offen offset:256 nt
    s_waitcnt vmcnt(3)
    s_cbranch_scc1 L_cw42_2
    s_waitcnt vmcnt(2)
L_cw42_2:
    buffer_load_dwordx4 v[196:199], v20, s[12:15], s49 offen offset:1536 nt
    s_waitcnt vmcnt(3)
    s_cbranch_scc1 L_cw43_2
    s_waitcnt vmcnt(2)
L_cw43_2:
    buffer_load_dwordx4 v[200:203], v20, s[12:15], s50 offen offset:0 nt
    v_mfma_f32_16x16x32_bf16 v[116:119], v[120:123], v[128:131], 0
    v_mfma_f32_16x16x32_bf16 v[116:119], v[124:127], v[132:135], v[116:119]
    s_waitcnt vmcnt(3)
    s_bitcmp1_b32 s99, 0
    s_cbranch_scc1 L_cw44_2
    s_waitcnt vmcnt(2)
L_cw44_2:
    buffer_load_dwordx4 v[204:207], v21, s[12:15], s49 offen offset:1792 nt
    buffer_load_dwordx4 v[40:43], v26, s[40:43], s75 offen sc1
    s_waitcnt vmcnt(4)
    s_cbranch_scc1 L_cw46_3
    s_waitcnt vmcnt(3)
L_cw46_3:
    buffer_load_dwordx4 v[208:211], v20, s[12:15], s51 offen offset:0 nt
    s_waitcnt vmcnt(4)
    s_cbranch_scc1 L_cw47_3
    s_waitcnt vmcnt(3)
L_cw47_3:
    buffer_load_dwordx4 v[212:215], v20, s[12:15], s51 offen offset:3072 nt
    buffer_load_dwordx4 v[216:219], v21, s[12:15], s51 offen offset:256 nt
    buffer_load_dwordx4 v[220:223], v20, s[12:15], s51 offen offset:1536 nt
    s_waitcnt vmcnt(5)
    buffer_load_dwordx4 v[224:227], v20, s[12:15], s52 offen offset:0 nt
    s_waitcnt vmcnt(4)
    buffer_load_dwordx4 v[228:231], v21, s[12:15], s51 offen offset:1792 nt
L_mchk:
    v_perm_b32 v9, v41, v40, s66
    v_perm_b32 v10, v43, v42, s67
    v_or_b32 v9, v9, v10
    v_cmp_ne_u32 vcc, v9, v8
    s_cbranch_vccz L_mok
    s_add_u32 s69, s69, 1
    s_cmp_gt_u32 s69, 20000
    s_cbranch_scc1 L_mok
    s_mov_b64 exec, vcc
    buffer_load_dwordx4 v[40:43], v26, s[40:43], s75 offen sc1
    s_waitcnt vmcnt(0)
    s_branch L_mchk
L_mok:
    s_mov_b64 exec, -1
    s_load_dword s79, s[40:41], s58
    s_mov_b32 s69, 0
    v_and_b32 v40, s68, v40
    v_and_b32 v41, s68, v41
    v_mul_f32 v40, s73, v40
    s_waitcnt vmcnt(4)
    buffer_load_dwordx4 v[232:235], v20, s[12:15], s100 offen offset:0 nt
    v_max_f32_dpp v42, v40, v40 quad_perm:[1,0,3,2] row_mask:0xf bank_mask:0xf
    s_nop 1
    v_max_f32_dpp v42, v42, v42 quad_perm:[2,3,0,1] row_mask:0xf bank_mask:0xf
    s_nop 1
    v_max_f32_dpp v42, v42, v42 row_half_mirror row_mask:0xf bank_mask:0xf
    s_nop 1
    v_max_f32_dpp v42, v42, v42 row_mirror row_mask:0xf bank_mask:0xf
    v_mov_b32 v43, v42
    s_nop 1
    v_permlane16_swap_b32 v43, v42
    v_max_f32 v42, v42, v43
    v_sub_f32 v40, v40, v42
    v_sub_f32 v44, v44, v42
    v_exp_f32 v40, v40
    v_exp_f32 v44, v44
    v_mul_f32 v41, v41, v40
    s_nop 1
    v_add_f32_dpp v41, v41, v41 quad_perm:[1,0,3,2] row_mask:0xf bank_mask:0xf
    s_nop 1
    v_add_f32_dpp v41, v41, v41 quad_perm:[2,3,0,1] row_mask:0xf bank_mask:0xf
    s_nop 1
    v_add_f32_dpp v41, v41, v41 row_half_mirror row_mask:0xf bank_mask:0xf
    s_nop 1
    v_add_f32_dpp v41, v41, v41 row_mirror row_mask:0xf bank_mask:0xf
    v_mov_b32 v43, v41
    s_nop 1
    v_permlane16_swap_b32 v43, v41
    v_add_f32 v41, v41, v43
    v_rcp_f32 v41, v41
    s_nop 0
    v_mul_f32 v44, v44, v41
    v_mul_f32 v32, v32, v44
    v_mul_f32 v33, v33, v44
    v_mul_f32 v34, v34, v44
    v_mul_f32 v35, v35, v44
    v_cvt_pk_bf16_f32 v32, v32, v32
    v_cvt_pk_bf16_f32 v33, v33, v33
    v_cvt_pk_bf16_f32 v34, v34, v34
    v_cvt_pk_bf16_f32 v35, v35, v35
    s_waitcnt vmcnt(4)
    buffer_load_dwordx4 v[236:239], v20, s[12:15], s100 offen offset:3072 nt
    v_and_b32 v72, v32, v4
    v_and_b32 v73, v32, v5
    v_and_b32_dpp v74, v32, v6 row_shr:4 row_mask:0xf bank_mask:0xf bound_ctrl:0
    v_and_b32_dpp v75, v32, v7 row_shr:4 row_mask:0xf bank_mask:0xf bound_ctrl:0
    v_and_b32_dpp v76, v32, v4 row_shl:4 row_mask:0xf bank_mask:0xf bound_ctrl:0
    v_and_b32_dpp v77, v32, v5 row_shl:4 row_mask:0xf bank_mask:0xf bound_ctrl:0
    v_and_b32 v78, v32, v6
    v_and_b32 v79, v32, v7
    v_and_b32 v80, v33, v4
    v_and_b32 v81, v33, v5
    v_and_b32_dpp v82, v33, v6 row_shr:4 row_mask:0xf bank_mask:0xf bound_ctrl:0
    v_and_b32_dpp v83, v33, v7 row_shr:4 row_mask:0xf bank_mask:0xf bound_ctrl:0
    v_and_b32_dpp v84, v33, v4 row_shl:4 row_mask:0xf bank_mask:0xf bound_ctrl:0
    v_and_b32_dpp v85, v33, v5 row_shl:4 row_mask:0xf bank_mask:0xf bound_ctrl:0
    v_and_b32 v86, v33, v6
    v_and_b32 v87, v33, v7
    v_and_b32 v88, v34, v4
    v_and_b32 v89, v34, v5
    v_and_b32_dpp v90, v34, v6 row_shr:4 row_mask:0xf bank_mask:0xf bound_ctrl:0
    v_and_b32_dpp v91, v34, v7 row_shr:4 row_mask:0xf bank_mask:0xf bound_ctrl:0
    v_and_b32_dpp v92, v34, v4 row_shl:4 row_mask:0xf bank_mask:0xf bound_ctrl:0
    v_and_b32_dpp v93, v34, v5 row_shl:4 row_mask:0xf bank_mask:0xf bound_ctrl:0
    v_and_b32 v94, v34, v6
    v_and_b32 v95, v34, v7
    v_and_b32 v96, v35, v4
    v_and_b32 v97, v35, v5
    v_and_b32_dpp v98, v35, v6 row_shr:4 row_mask:0xf bank_mask:0xf bound_ctrl:0
    v_and_b32_dpp v99, v35, v7 row_shr:4 row_mask:0xf bank_mask:0xf bound_ctrl:0
    v_and_b32_dpp v100, v35, v4 row_shl:4 row_mask:0xf bank_mask:0xf bound_ctrl:0
    v_and_b32_dpp v101, v35, v5 row_shl:4 row_mask:0xf bank_mask:0xf bound_ctrl:0
    v_and_b32 v102, v35, v6
    v_and_b32 v103, v35, v7
    v_mfma_f32_16x16x32_bf16 v[104:107], v[72:75], v[160:163], 0
    v_mfma_f32_16x16x32_bf16 v[108:111], v[72:75], v[164:167], 0
    v_mfma_f32_16x16x32_bf16 v[112:115], v[72:75], v[168:171], 0
    v_mfma_f32_16x16x32_bf16 v[104:107], v[76:79], v[172:175], v[104:107]
    v_mfma_f32_16x16x32_bf16 v[108:111], v[76:79], v[176:179], v[108:111]
    v_mfma_f32_16x16x32_bf16 v[112:115], v[76:79], v[180:183], v[112:115]
    v_mfma_f32_16x16x32_bf16 v[104:107], v[80:83], v[184:187], v[104:107]
    v_mfma_f32_16x16x32_bf16 v[108:111], v[80:83], v[188:191], v[108:111]
    v_mfma_f32_16x16x32_bf16 v[112:115], v[80:83], v[192:195], v[112:115]
    v_mfma_f32_16x16x32_bf16 v[104:107], v[84:87], v[196:199], v[104:107]
    v_mfma_f32_16x16x32_bf16 v[108:111], v[84:87], v[200:203], v[108:111]
    v_mfma_f32_16x16x32_bf16 v[112:115], v[84:87], v[204:207], v[112:115]
    v_mfma_f32_16x16x32_bf16 v[104:107], v[88:91], v[208:211], v[104:107]
    v_mfma_f32_16x16x32_bf16 v[108:111], v[88:91], v[212:215], v[108:111]
    v_mfma_f32_16x16x32_bf16 v[112:115], v[88:91], v[216:219], v[112:115]
    s_waitcnt vmcnt(4)
    buffer_load_dwordx4 v[240:243], v21, s[12:15], s100 offen offset:256 nt
    s_waitcnt vmcnt(4)
    s_bitcmp1_b32 240, s44
    s_cbranch_scc1 L_cw55_2
    s_waitcnt vmcnt(2)
L_cw55_2:
    buffer_load_dwordx4 v[244:247], v20, s[12:15], s100 offen offset:1536 nt
    s_waitcnt vmcnt(4)
    s_cbranch_scc1 L_cw56_2
    s_waitcnt vmcnt(2)
L_cw56_2:
    buffer_load_dwordx4 v[248:251], v20, s[12:15], s101 offen offset:0 nt
    v_mfma_f32_16x16x32_bf16 v[104:107], v[92:95], v[220:223], v[104:107]
    v_mfma_f32_16x16x32_bf16 v[108:111], v[92:95], v[224:227], v[108:111]
    v_mfma_f32_16x16x32_bf16 v[112:115], v[92:95], v[228:231], v[112:115]
    s_waitcnt vmcnt(4)
    s_bitcmp1_b32 240, s44
    s_cbranch_scc1 L_cw57_2
    s_waitcnt vmcnt(2)
L_cw57_2:
    buffer_load_dwordx4 v[252:255], v21, s[12:15], s100 offen offset:1792 nt
    s_cmp_gt_u32 s44, 3
    s_cbranch_scc1 L_w58
    s_waitcnt vmcnt(3)
L_w58:
    buffer_load_dwordx4 v[140:143], v2, s[20:23], 0 offen offset:1280 nt
    s_cmp_gt_u32 s44, 3
    s_cbranch_scc1 L_w59
    s_waitcnt vmcnt(3)
L_w59:
    buffer_load_dwordx4 v[144:147], v2, s[20:23], 0 offen offset:2560 nt
    s_cmp_gt_u32 s44, 3
    s_cbranch_scc1 L_w60
    s_waitcnt vmcnt(3)
L_w60:
    buffer_load_dwordx4 v[148:151], v2, s[20:23], 0 offen offset:3840 nt
    s_cmp_gt_u32 s44, 3
    s_cbranch_scc1 L_w61
    s_waitcnt vmcnt(3)
L_w61:
    s_waitcnt vmcnt(7)
    buffer_load_dwordx4 v[152:155], v1, s[20:23], s53 offen offset:0 nt
    s_waitcnt vmcnt(7)
    buffer_load_dwordx4 v[156:159], v1, s[20:23], s53 offen offset:1280 nt
    v_mfma_f32_16x16x32_bf16 v[104:107], v[96:99], v[232:235], v[104:107]
    v_mfma_f32_16x16x32_bf16 v[108:111], v[96:99], v[236:239], v[108:111]
    v_mfma_f32_16x16x32_bf16 v[112:115], v[96:99], v[240:243], v[112:115]
    s_waitcnt vmcnt(5)
    v_mfma_f32_16x16x32_bf16 v[104:107], v[100:103], v[244:247], v[104:107]
    v_mfma_f32_16x16x32_bf16 v[108:111], v[100:103], v[248:251], v[108:111]
    v_mfma_f32_16x16x32_bf16 v[112:115], v[100:103], v[252:255], v[112:115]
    s_mov_b32 exec_hi, 0
    s_nop 4
    ds_write_b128 v16, v[104:107]
    s_not_b64 exec, exec
    ds_write_b128 v16, v[108:111]
    s_mov_b32 exec_lo, 0x00ff00ff
    s_mov_b32 exec_hi, 0xff00ff00
    ds_write_b128 v17, v[112:115] offset:512
    s_mov_b64 exec, -1
    s_cmp_lg_u64 s[70:71], 0
    s_waitcnt lgkmcnt(0)
    s_barrier
    ds_read_b128 v[32:35], v3
    ds_read_b128 v[36:39], v3 offset:816
    s_waitcnt lgkmcnt(0)
    v_pk_add_f32 v[32:33], v[32:33], v[36:37]
    v_pk_add_f32 v[34:35], v[34:35], v[38:39]
    s_nop 0
    v_add_f32_dpp v32, v32, v32 quad_perm:[1,0,3,2] row_mask:0xf bank_mask:0xf
    v_add_f32_dpp v33, v33, v33 quad_perm:[1,0,3,2] row_mask:0xf bank_mask:0xf
    v_add_f32_dpp v34, v34, v34 quad_perm:[1,0,3,2] row_mask:0xf bank_mask:0xf
    v_add_f32_dpp v35, v35, v35 quad_perm:[1,0,3,2] row_mask:0xf bank_mask:0xf
    v_add_f32_dpp v32, v32, v32 quad_perm:[2,3,0,1] row_mask:0xf bank_mask:0xf
    v_add_f32_dpp v33, v33, v33 quad_perm:[2,3,0,1] row_mask:0xf bank_mask:0xf
    v_add_f32_dpp v34, v34, v34 quad_perm:[2,3,0,1] row_mask:0xf bank_mask:0xf
    v_add_f32_dpp v35, v35, v35 quad_perm:[2,3,0,1] row_mask:0xf bank_mask:0xf
    v_add_f32_dpp v32, v32, v32 row_half_mirror row_mask:0xf bank_mask:0xf
    v_add_f32_dpp v33, v33, v33 row_half_mirror row_mask:0xf bank_mask:0xf
    v_add_f32_dpp v34, v34, v34 row_half_mirror row_mask:0xf bank_mask:0xf
    v_add_f32_dpp v35, v35, v35 row_half_mirror row_mask:0xf bank_mask:0xf
    v_perm_b32 v48, v32, v8, s62
    v_perm_b32 v49, v33, v8, s63
    v_perm_b32 v50, v34, v8, s64
    v_perm_b32 v51, v35, v8, s65
    s_mov_b64 exec, s[76:77]
    s_cbranch_scc1 L_slow_o
    buffer_store_dwordx4 v[48:51], v31, s[40:43], s59 offen offset:3072
L_back_o:
    s_mov_b64 exec, -1
    buffer_load_dwordx4 v[176:179], v25, s[40:43], s61 offen offset:3072 sc1
    s_add_u32 s57, s59, 4096
    s_lshl_b32 s72, s44, 8
    v_lshrrev_b32 v18, 1, v26
    v_add_u32 v18, s72, v18
    v_cmp_lt_u32 vcc, 639, v18
    v_mov_b32 v9, 192
    v_mov_b32 v10, 1120
    v_lshrrev_b32 v30, 1, v18
    v_lshrrev_b32 v19, 2, v18
    v_cndmask_b32 v9, 0, v9, vcc
    v_cndmask_b32 v10, 0, v10, vcc
    v_add_u32 v30, v30, v9
    v_add_u32 v19, v19, v10
    v_and_b32 v9, 63, v18
    v_xor_b32 v18, v18, v9
    v_lshl_add_u32 v18, v18, 1, v9
    s_mul_i32 s73, s46, 160
    s_mov_b32 s74, 0
    s_mov_b32 s75, 0x41380000
    s_mov_b32 s57, 2359296
    s_or_b32 s72, s46, s44
    v_cmp_ne_u32 vcc, s79, v8
    s_cbranch_vccnz L_fslow
L_fok:
L_ochk:
    s_waitcnt vmcnt(0)
    v_perm_b32 v9, v177, v176, s66
    v_perm_b32 v10, v179, v178, s67
    v_and_b32 v40, s68, v176
    v_and_b32 v41, s68, v177
    v_or_b32 v9, v9, v10
    v_and_b32 v42, s68, v178
    v_and_b32 v43, s68, v179
    v_cmp_ne_u32 vcc, v9, v8
    s_cbranch_vccz L_ook
    s_mov_b64 exec, vcc
    buffer_load_dwordx4 v[176:179], v25, s[40:43], s61 offen offset:3072 sc1
    s_add_u32 s69, s69, 1
    s_cmp_gt_u32 s69, 20000
    s_cbranch_scc0 L_ochk
L_ook:
    s_mov_b64 exec, -1
    v_add_f32_dpp v40, v40, v40 quad_perm:[1,0,3,2] row_mask:0xf bank_mask:0xf
    v_add_f32_dpp v41, v41, v41 quad_perm:[1,0,3,2] row_mask:0xf bank_mask:0xf
    v_add_f32_dpp v42, v42, v42 quad_perm:[1,0,3,2] row_mask:0xf bank_mask:0xf
    v_add_f32_dpp v43, v43, v43 quad_perm:[1,0,3,2] row_mask:0xf bank_mask:0xf
    v_add_f32_dpp v40, v40, v40 quad_perm:[2,3,0,1] row_mask:0xf bank_mask:0xf
    v_add_f32_dpp v41, v41, v41 quad_perm:[2,3,0,1] row_mask:0xf bank_mask:0xf
    v_add_f32_dpp v42, v42, v42 quad_perm:[2,3,0,1] row_mask:0xf bank_mask:0xf
    v_add_f32_dpp v43, v43, v43 quad_perm:[2,3,0,1] row_mask:0xf bank_mask:0xf
    v_cvt_pk_bf16_f32 v40, v40, v40
    v_cvt_pk_bf16_f32 v41, v41, v41
    v_cvt_pk_bf16_f32 v42, v42, v42
    v_cvt_pk_bf16_f32 v43, v43, v43
    v_cndmask_b32 v44, v40, v42, s[54:55]
    v_cndmask_b32 v45, v41, v43, s[54:55]
    v_and_b32 v72, v40, v4
    v_and_b32 v73, v40, v5
    v_and_b32_dpp v74, v40, v6 row_shr:4 row_mask:0xf bank_mask:0xf bound_ctrl:0
    v_and_b32_dpp v75, v40, v7 row_shr:4 row_mask:0xf bank_mask:0xf bound_ctrl:0
    v_and_b32 v76, v41, v4
    v_and_b32 v77, v41, v5
    v_and_b32_dpp v78, v41, v6 row_shr:4 row_mask:0xf bank_mask:0xf bound_ctrl:0
    v_and_b32_dpp v79, v41, v7 row_shr:4 row_mask:0xf bank_mask:0xf bound_ctrl:0
    v_mfma_f32_16x16x32_bf16 v[116:119], v[72:75], v[136:139], v[116:119]
    v_and_b32 v80, v42, v4
    v_and_b32 v81, v42, v5
    v_and_b32_dpp v82, v42, v6 row_shr:4 row_mask:0xf bank_mask:0xf bound_ctrl:0
    v_and_b32_dpp v83, v42, v7 row_shr:4 row_mask:0xf bank_mask:0xf bound_ctrl:0
    v_mfma_f32_16x16x32_bf16 v[116:119], v[76:79], v[140:143], v[116:119]
    v_and_b32 v84, v43, v4
    v_and_b32 v85, v43, v5
    v_and_b32_dpp v86, v43, v6 row_shr:4 row_mask:0xf bank_mask:0xf bound_ctrl:0
    v_and_b32_dpp v87, v43, v7 row_shr:4 row_mask:0xf bank_mask:0xf bound_ctrl:0
    v_mfma_f32_16x16x32_bf16 v[116:119], v[80:83], v[144:147], v[116:119]
    v_and_b32_dpp v88, v44, v4 row_shl:4 row_mask:0xf bank_mask:0xf bound_ctrl:0
    v_and_b32_dpp v89, v44, v5 row_shl:4 row_mask:0xf bank_mask:0xf bound_ctrl:0
    v_and_b32 v90, v44, v6
    v_and_b32 v91, v44, v7
    v_mfma_f32_16x16x32_bf16 v[116:119], v[84:87], v[148:151], v[116:119]
    v_and_b32_dpp v92, v45, v4 row_shl:4 row_mask:0xf bank_mask:0xf bound_ctrl:0
    v_and_b32_dpp v93, v45, v5 row_shl:4 row_mask:0xf bank_mask:0xf bound_ctrl:0
    v_and_b32 v94, v45, v6
    v_and_b32 v95, v45, v7
    v_mfma_f32_16x16x32_bf16 v[116:119], v[88:91], v[152:155], v[116:119]
    s_nop 0
    v_mfma_f32_16x16x32_bf16 v[116:119], v[92:95], v[156:159], v[116:119]
    s_nop 7
    ds_write_b128 v29, v[116:119]
    s_waitcnt lgkmcnt(0)
    s_barrier
    s_cmp_gt_u32 s44, 4
    s_cbranch_scc1 L_end
    s_mov_b32 exec_hi, 0
    ds_read2st64_b32 v[32:33], v30 offset0:88 offset1:92
    ds_read2st64_b32 v[34:35], v30 offset0:96 offset1:100
    ds_read2st64_b32 v[36:37], v30 offset0:104 offset1:108
    ds_read2st64_b32 v[38:39], v30 offset0:112 offset1:116
    s_waitcnt lgkmcnt(2)
    v_pk_add_f32 v[32:33], v[32:33], v[34:35]
    s_waitcnt lgkmcnt(0)
    v_pk_add_f32 v[36:37], v[36:37], v[38:39]
    v_pk_add_f32 v[32:33], v[32:33], v[36:37]
    v_add_f32 v32, v32, v33
    v_cvt_f64_f32 v[34:35], v32
    v_add_f64 v[32:33], v[34:35], s[74:75]
    buffer_atomic_add_x2 v[32:33], v18, s[40:43], s56 offen sc0
    v_add_f64 v[36:37], v[34:35], s[74:75]
    s_cmp_lg_u32 s72, 0
    s_waitcnt vmcnt(0)
    v_lshl_add_u64 v[32:33], v[32:33], 0, v[36:37]
    v_lshrrev_b32 v9, 20, v33
    v_add_f64 v[32:33], v[32:33], -s[74:75]
    v_cmp_eq_u32 vcc, 0x413, v9
    v_cvt_f32_f64 v32, v[32:33]
    v_cvt_pk_bf16_f32 v32, v32, v32
    s_mov_b64 exec, vcc
    buffer_store_short v32, v19, s[36:39], s73 offen
    s_cbranch_scc1 L_end
    s_and_b64 exec, exec, 1
    buffer_store_dword v8, off, s[40:43], s57
    s_endpgm
L_end:
    s_endpgm
L_qre1:
    s_cmp_lg_u32 s44, 1
    s_cbranch_scc1 L_qre1d
    s_mov_b32 exec_hi, 0xffff
    buffer_store_dwordx4 v[252:255], v251, s[40:43], s78 offen sc1
    s_mov_b32 exec_hi, -1
    s_branch L_qre1d
L_qre2:
    s_cmp_lg_u32 s44, 1
    s_cbranch_scc1 L_qre2d
    s_mov_b32 exec_hi, 0xffff
    buffer_store_dwordx4 v[252:255], v251, s[40:43], s78 offen sc1
    s_mov_b32 exec_hi, -1
    s_branch L_qre2d
L_slow_m:
    buffer_store_dwordx4 v[36:39], v45, s[40:43], s74 offen  sc1
    s_branch L_back_m
L_slow_o:
    buffer_store_dwordx4 v[48:51], v31, s[40:43], s59 offen offset:3072  sc1
    s_branch L_back_o
L_init:
    v_and_b32 v160, 63, v0
    v_mov_b32 v161, 1120
    v_cmp_lt_u32 vcc, 19, v160
    s_mul_i32 s72, s46, 160
    s_nop 0
    v_cndmask_b32 v161, 0, v161, vcc
    v_lshl_add_u32 v161, v160, 3, v161
    v_add_u32 v161, s72, v161
    s_mov_b32 exec_hi, 0xff
    ds_read_b64 v[162:163], v161 offset:49152
    v_lshlrev_b32 v160, 5, v160
    v_and_b32 v161, 63, v160
    v_xor_b32 v160, v160, v161
    v_lshl_add_u32 v160, v160, 1, v161
    s_mov_b32 s72, 0
    s_mov_b32 s73, 0x41380000
    s_waitcnt lgkmcnt(0)
    v_lshlrev_b32 v164, 16, v162
    v_and_b32 v165, 0xffff0000, v162
    v_lshlrev_b32 v166, 16, v163
    v_and_b32 v167, 0xffff0000, v163
    v_cvt_f64_f32 v[168:169], v164
    v_cvt_f64_f32 v[170:171], v165
    v_cvt_f64_f32 v[172:173], v166
    v_cvt_f64_f32 v[174:175], v167
    v_add_f64 v[168:169], v[168:169], s[72:73]
    v_add_f64 v[170:171], v[170:171], s[72:73]
    v_add_f64 v[172:173], v[172:173], s[72:73]
    v_add_f64 v[174:175], v[174:175], s[72:73]
    v_subrev_u32 v169, 0x27000000, v169
    v_subrev_u32 v171, 0x27000000, v171
    v_subrev_u32 v173, 0x27000000, v173
    v_subrev_u32 v175, 0x27000000, v175
    buffer_store_dwordx4 v[168:171], v160, s[40:43], s56 offen sc1
    buffer_store_dwordx4 v[172:175], v160, s[40:43], s56 offen offset:16 sc1
    s_mov_b64 exec, -1
    s_branch L_initd
L_flag:
    v_lshlrev_b32 v9, 3, v26
    s_add_u32 s58, s56, 4096
    s_mov_b64 exec, 1
    buffer_store_dword v8, v9, s[40:43], s58 offen sc1
    s_mov_b64 exec, -1
    s_branch L_flagd
L_fslow:
    buffer_load_dword v46, off, s[40:43], s58 sc1
    s_add_u32 s69, s69, 1
    s_cmp_gt_u32 s69, 20000
    s_cbranch_scc1 L_fok
    s_waitcnt vmcnt(0)
    v_cmp_ne_u32 vcc, v46, v8
    s_cbranch_vccnz L_fslow
    s_branch L_fok
L_qsl:
    s_cmp_eq_u32 s69, 0
    s_cbranch_scc1 L_qre1
L_qre1d:
    s_add_u32 s69, s69, 1
    s_cmp_gt_u32 s69, 20000
    s_cbranch_scc1 L_qok
    s_mov_b64 exec, vcc
    buffer_load_dwordx4 v[56:59], v250, s[40:43], s60 offen sc1
    s_waitcnt vmcnt(0)
    s_branch L_qchk
.section .rodata,"a"
.p2align 6
.amdhsa_kernel parallel_sum__sliding_block_cached__glu_gated_geglu__decode_kernel
  .amdhsa_next_free_vgpr 256
  .amdhsa_next_free_sgpr 102
  .amdhsa_accum_offset 256
  .amdhsa_group_segment_fixed_size 0
  .amdhsa_kernarg_size 96
  .amdhsa_user_sgpr_count 2
  .amdhsa_user_sgpr_kernarg_segment_ptr 1
  .amdhsa_system_sgpr_workgroup_id_x 1
.end_amdhsa_kernel
```
